```python
import torch

def _softmax(x, axis=-1):
    return torch.softmax(x, dim=axis)
def _gelu(x):
    return torch.nn.functional.gelu(x, approximate="tanh")
def _silu(x):
    return torch.nn.functional.silu(x)
def _sigmoid(x):
    return torch.sigmoid(x)
def _layernorm(x, axis=-1, eps=1e-5):
    m = x.mean(dim=axis, keepdim=True)
    v = x.var(dim=axis, keepdim=True, unbiased=False)
    return (x - m) / torch.sqrt(v + eps)
def _scatter_add(tgt, idx, src, axis=0):
    return tgt.clone().index_add_(axis, idx, src)
def _segment_sum(src, seg, n):
    out = torch.zeros((n,) + src.shape[1:], dtype=src.dtype)
    return out.index_add_(0, seg, src)
def _pad(x, pw):
    flat = tuple(v for pair in reversed(pw) for v in pair)
    return torch.nn.functional.pad(x, flat)

kernel_name = 'standalone__sequential_behavior_din__recsys'

def setup_inputs():

    _w = (lambda a: (lambda t: t.to(torch.bfloat16) if t.is_floating_point() else t)(torch.as_tensor(a)))
    B, L, D = 16384, 20, 64
    H = D
    return {
        "target": _w((lambda *s: torch.randn(*s, dtype=torch.bfloat16) * 1.6)(B, D)),
        "hist": _w((lambda *s: torch.randn(*s, dtype=torch.bfloat16) * 1.6)(B, L, D)),
        "mask": _w((lambda lo, hi, *s: torch.randint(lo, hi, s))(0, 2, B, L).to(float)),
        "w1": _w((lambda *s: torch.randn(*s, dtype=torch.bfloat16) * 1.6)(4 * D, H) * (4 * D) ** -0.5),
        "b1": _w((lambda *s: torch.randn(*s, dtype=torch.bfloat16) * 12.8)(H) * 0.1),
        "w2": _w((lambda *s: torch.randn(*s, dtype=torch.bfloat16) * 0.05)(H, 1) * H ** -0.5),
        "b2": _w((lambda *s: torch.randn(*s, dtype=torch.bfloat16) * 0.2)(1) * 0.1),
    }

def reference(target, hist, mask, w1, b1, w2, b2):
    L = hist.shape[1]
    tgt = (lambda x, n, axis: torch.repeat_interleave(x, n, dim=axis))(target[:, None, :], L, axis=1)
    feat = torch.concatenate([hist, tgt, hist - tgt, hist * tgt], axis=-1)
    h = _sigmoid(feat @ w1 + b1)
    scores = (h @ w2 + b2)[..., 0] * mask
    return torch.einsum('bl,bld->bd', scores, hist)
```

```asm
; @launch grid=(256,1,1) block=(512,1,1) lds=114688
.amdgcn_target "amdgcn-amd-amdhsa--gfx950"
.text
.globl standalone__sequential_behavior_din__recsys_kernel
.p2align 8
.type standalone__sequential_behavior_din__recsys_kernel,@function
standalone__sequential_behavior_din__recsys_kernel:
    s_load_dwordx4 s[8:11], s[0:1], 16
    s_getpc_b64 s[88:89]
L_pc:
    s_and_b32 s52, s2, 0x78
    s_lshl_b32 s52, s52, 7
    v_and_b32 v20, 0x1e0, v0
    v_lshl_add_u32 v20, v20, 1, s52
    v_min_u32 v20, L_end-L_pc-320, v20
    global_load_dword v21, v20, s[88:89] offset:320
    v_lshrrev_b32 v2, 6, v0
    s_cmp_ge_u32 s2, 0x100
    v_readfirstlane_b32 s20, v2
    s_cbranch_scc1 L_end
    v_and_b32 v1, 63, v0
    s_and_b32 s21, s20, 3
    s_lshl2_add_u32 s22, s2, s21
    s_cmp_lt_u32 s20, 4
    s_cbranch_scc1 L_l0
    s_and_b32 s53, s21, 1
    s_lshl_b32 s52, s21, 11
    s_lshl_b32 s53, s53, 6
    s_or_b32 s53, s53, s52
    v_and_b32 v26, 16, v1
    v_lshlrev_b32 v24, 4, v1
    v_lshlrev_b32 v22, 1, v26
    v_xor_b32 v22, v22, v24
    v_xor_b32 v28, s53, v22
    v_add_u32 v29, 8192, v28
    v_add_u32 v30, 16384, v28
    v_add_u32 v31, 24576, v28
    s_add_u32 s52, s52, 69632
    s_add_u32 m0, s52, 8192
    v_lshrrev_b32 v25, 4, v1
    v_and_b32 v27, 15, v1
    s_lshl_b32 s53, s22, 11
    v_lshl_add_u32 v23, v27, 7, s53
    v_lshl_add_u32 v23, v25, 5, v23
    s_waitcnt lgkmcnt(0)
    s_load_dwordx2 s[4:5], s[0:1], 0
    global_load_dwordx4 v[32:35], v30, s[10:11] offset:0
    global_load_dwordx4 v[44:47], v30, s[10:11] offset:1024
    global_load_dwordx4 v[40:43], v29, s[10:11] offset:0
    global_load_dwordx4 v[52:55], v29, s[10:11] offset:1024
    global_load_dwordx4 v[36:39], v28, s[10:11] offset:0
    global_load_dwordx4 v[48:51], v28, s[10:11] offset:1024
    s_waitcnt lgkmcnt(0)
    global_load_dwordx4 v[56:59], v23, s[4:5]
    global_load_dwordx4 v[60:63], v23, s[4:5] offset:16
    global_load_lds_dwordx4 v31, s[10:11]
    global_load_lds_dwordx4 v31, s[10:11] offset:1024
    s_branch L_c1
L_l0:
    s_setprio 3
    s_mul_i32 s52, s22, 640
    v_lshlrev_b32 v29, 4, v1
    v_add_u32 v28, s52, v29
    s_mul_i32 s53, s21, 640
    s_add_u32 s53, s53, 112128
    s_mov_b32 m0, s53
    v_lshl_add_u32 v30, v1, 1, s53
    s_movk_i32 exec_hi, 0xff
    s_waitcnt lgkmcnt(0)
    global_load_lds_dwordx4 v28, s[8:9]
    s_load_dwordx4 s[4:7], s[0:1], 0
    s_load_dwordx8 s[12:19], s[0:1], 32
    s_mov_b32 m0, 110848
    s_mov_b64 exec, 0xff
    s_mul_i32 s52, s22, 40960
    s_waitcnt lgkmcnt(0)
    global_load_lds_dwordx4 v29, s[12:13]
    s_mov_b64 exec, -1
    v_lshlrev_b32 v29, 1, v1
    global_load_ushort v179, v29, s[14:15]
    s_mov_b32 s50, 40960
    s_mov_b32 s51, 0x20000
    s_mul_i32 s34, s21, 1280
    s_add_u32 s34, s34, 95232
    s_mov_b32 s42, 0xff80
    s_lshl_b32 s41, s21, 12
    v_mov_b32 v64, s42
    v_mov_b32 v65, s42
    v_mov_b32 v66, s42
    v_mov_b32 v67, s42
    v_lshl_add_u32 v68, v1, 4, s34
    v_lshl_add_u32 v69, v1, 2, s34
    ds_write_b128 v68, v[64:67]
    ds_write_b32 v69, v64 offset:1024
    v_mul_u32_u24 v7, 8414824, v1
    v_add_u32 v8, 0x20199a00, v7
    v_add_u32 v9, 0x40333400, v7
    v_add_u32 v10, 0x604cce00, v7
    v_add_u32 v11, 0x80666800, v7
    v_lshrrev_b32 v23, 3, v1
    v_and_b32 v24, 7, v1
    v_lshl_add_u32 v56, v23, 4, s34
    v_and_b32 v54, 6, v23
    v_xor_b32 v54, v54, v24
    v_lshlrev_b32 v54, 4, v54
    v_xor_b32 v55, 16, v54
    v_and_b32 v23, 3, v23
    v_lshl_add_u32 v57, v24, 2, v23
    v_lshl_add_u32 v57, v57, 2, s34
    s_sub_u32 s3, s34, 124
    s_lshl2_add_u32 s53, s21, 111104
    v_mov_b32 v176, s53
    v_and_b32 v28, 3, v1
    v_mov_b32 v172, 0
    s_add_u32 s48, s6, s52
    s_addc_u32 s49, s7, 0
    s_waitcnt vmcnt(2)
    ds_read_u16 v2, v30 offset:0
    ds_read_u16 v3, v30 offset:128
    ds_read_u16 v4, v30 offset:256
    ds_read_u16 v5, v30 offset:384
    ds_read_u16 v6, v30 offset:512
    s_waitcnt lgkmcnt(0)
    v_cmp_ne_u32_e64 s[24:25], 0, v2
    v_cmp_ne_u32_e64 s[26:27], 0, v3
    v_cmp_ne_u32_e64 s[28:29], 0, v4
    v_cmp_ne_u32_e64 s[30:31], 0, v5
    v_cmp_ne_u32_e64 s[32:33], 0, v6
    s_mov_b64 exec, s[24:25]
    v_mbcnt_lo_u32_b32 v17, s24, 0
    v_mbcnt_hi_u32_b32 v17, s25, v17
    v_alignbit_b32 v12, v2, v7, 16
    v_lshl_add_u32 v17, v17, 2, s34
    ds_write_b32 v17, v12
    s_bcnt1_i32_b64 s52, s[24:25]
    s_lshl2_add_u32 s35, s52, s34
    s_mov_b64 exec, s[26:27]
    v_mbcnt_lo_u32_b32 v18, s26, 0
    v_mbcnt_hi_u32_b32 v18, s27, v18
    v_alignbit_b32 v13, v3, v8, 16
    v_lshl_add_u32 v18, v18, 2, s35
    ds_write_b32 v18, v13
    s_bcnt1_i32_b64 s52, s[26:27]
    s_lshl2_add_u32 s36, s52, s35
    s_mov_b64 exec, s[28:29]
    v_mbcnt_lo_u32_b32 v19, s28, 0
    v_mbcnt_hi_u32_b32 v19, s29, v19
    v_alignbit_b32 v14, v4, v9, 16
    v_lshl_add_u32 v19, v19, 2, s36
    ds_write_b32 v19, v14
    s_bcnt1_i32_b64 s52, s[28:29]
    s_lshl2_add_u32 s37, s52, s36
    s_mov_b64 exec, s[30:31]
    v_mbcnt_lo_u32_b32 v20, s30, 0
    v_mbcnt_hi_u32_b32 v20, s31, v20
    v_alignbit_b32 v15, v5, v10, 16
    v_lshl_add_u32 v20, v20, 2, s37
    ds_write_b32 v20, v15
    s_bcnt1_i32_b64 s52, s[30:31]
    s_lshl2_add_u32 s38, s52, s37
    s_mov_b64 exec, s[32:33]
    v_mbcnt_lo_u32_b32 v21, s32, 0
    v_mbcnt_hi_u32_b32 v21, s33, v21
    v_alignbit_b32 v16, v6, v11, 16
    v_lshl_add_u32 v21, v21, 2, s38
    ds_write_b32 v21, v16
    s_bcnt1_i32_b64 s52, s[32:33]
    s_lshl2_add_u32 s52, s52, s38
    s_sub_u32 s52, s52, s3
    s_lshr_b32 s23, s52, 7
    s_max_u32 s3, s23, 6
    s_sub_u32 s3, s3, 6
    s_lshl_b32 s53, s3, 7
    s_mov_b64 exec, -1
    v_add_u32 v58, s53, v56
    ds_read_b128 v[148:151], v58 offset:640
    ds_read_b128 v[152:155], v58 offset:512
    ds_read_b128 v[156:159], v58 offset:384
    global_load_ushort v174, v172, s[16:17]
    s_add_u32 s52, s3, 1
    s_and_b32 s52, s52, 3
    s_lshl_b32 s43, s52, 14
    s_add_u32 m0, s43, s41
    v_mov_b32 v168, s23
    v_add_u32 v59, s53, v57
    s_waitcnt lgkmcnt(2)
    v_and_or_b32 v148, v148, s42, v54
    buffer_load_dwordx4 v148, s[48:51], 0 offen nt lds
    s_add_u32 m0, m0, 0x400
    v_and_or_b32 v149, v149, s42, v55
    buffer_load_dwordx4 v149, s[48:51], 0 offen nt lds
    s_add_u32 m0, m0, 0x400
    v_and_or_b32 v150, v150, s42, v54
    buffer_load_dwordx4 v150, s[48:51], 0 offen nt lds
    s_add_u32 m0, m0, 0x400
    v_and_or_b32 v151, v151, s42, v55
    buffer_load_dwordx4 v151, s[48:51], 0 offen nt lds
    s_add_u32 m0, m0, 0xb400
    s_and_b32 m0, m0, 0xffff
    ds_write_b32 v176, v168
    ds_read_b128 v[2:5], v56 offset:256
    ds_read_b128 v[6:9], v56 offset:128
    ds_read_b128 v[10:13], v56 offset:0
    ds_read_b32 v173, v57 offset:640
    s_waitcnt lgkmcnt(5)
    s_setprio 0
    s_waitcnt vmcnt(5)
    v_lshlrev_b32 v179, 16, v179
    v_and_b32 v23, 0x7fffffff, v179
    v_and_b32 v24, 0x7f800000, v179
    v_lshlrev_b32 v29, 2, v1
    v_add_u32 v29, 110848, v29
    v_max_u32_dpp v24, v24, v24 row_ror:1 row_mask:0xf bank_mask:0xf
    s_nop 1
    v_max_u32_dpp v24, v24, v24 row_ror:2 row_mask:0xf bank_mask:0xf
    s_nop 1
    v_max_u32_dpp v24, v24, v24 row_ror:4 row_mask:0xf bank_mask:0xf
    s_nop 1
    v_max_u32_dpp v24, v24, v24 row_ror:8 row_mask:0xf bank_mask:0xf
    s_nop 1
    v_readlane_b32 s24, v24, 0
    v_readlane_b32 s25, v24, 16
    v_readlane_b32 s26, v24, 32
    v_readlane_b32 s27, v24, 48
    s_max_u32 s24, s24, s25
    s_max_u32 s26, s26, s27
    s_max_u32 s24, s24, s26
    s_max_u32 s24, s24, 0xf800000
    s_min_u32 s24, s24, 0x7e800000
    s_sub_u32 s46, s24, 0xf000000
    s_sub_u32 s25, s24, 0xe800000
    s_sub_u32 s24, 0x7f000000, s24
    v_max_u32 v23, s25, v23
    v_mul_f32 v23, s24, v23
    v_rcp_f32 v23, v23
    v_and_b32 v179, 0x80000000, v179
    v_or_b32 v23, v23, v179
    ds_write_b32 v29, v23 offset:384
    s_waitcnt lgkmcnt(0)
    s_barrier
    v_and_or_b32 v152, v152, s42, v54
    buffer_load_dwordx4 v152, s[48:51], 0 offen nt lds
    s_add_u32 m0, m0, 0x400
    v_and_or_b32 v153, v153, s42, v55
    buffer_load_dwordx4 v153, s[48:51], 0 offen nt lds
    s_add_u32 m0, m0, 0x400
    v_and_or_b32 v154, v154, s42, v54
    buffer_load_dwordx4 v154, s[48:51], 0 offen nt lds
    s_add_u32 m0, m0, 0x400
    v_and_or_b32 v155, v155, s42, v55
    buffer_load_dwordx4 v155, s[48:51], 0 offen nt lds
    s_add_u32 m0, m0, 0xb400
    s_and_b32 m0, m0, 0xffff
    v_and_or_b32 v2, v2, s42, v54
    v_and_or_b32 v3, v3, s42, v55
    v_and_or_b32 v4, v4, s42, v54
    v_and_or_b32 v5, v5, s42, v55
    v_and_or_b32 v6, v6, s42, v54
    v_and_or_b32 v7, v7, s42, v55
    v_and_or_b32 v8, v8, s42, v54
    v_and_or_b32 v9, v9, s42, v55
    v_and_or_b32 v10, v10, s42, v54
    v_and_or_b32 v11, v11, s42, v55
    v_and_or_b32 v12, v12, s42, v54
    v_and_or_b32 v13, v13, s42, v55
    v_lshrrev_b32 v26, 5, v1
    v_lshrrev_b32 v23, 2, v1
    v_and_or_b32 v24, v23, 6, v26
    v_lshlrev_b32 v24, 4, v24
    v_lshlrev_b32 v31, 3, v28
    v_xor_b32 v24, v24, v31
    v_lshl_add_u32 v60, v23, 7, v24
    v_add_u32 v60, s41, v60
    v_xor_b32 v61, 32, v60
    v_xor_b32 v62, 64, v60
    v_xor_b32 v63, 96, v60
    v_mov_b64 v[116:117], 0
    v_mov_b64 v[118:119], 0
    v_mov_b64 v[120:121], 0
    v_mov_b64 v[122:123], 0
    v_mov_b64 v[124:125], 0
    v_mov_b64 v[126:127], 0
    v_mov_b64 v[128:129], 0
    v_mov_b64 v[130:131], 0
    s_lshl_b32 s53, s22, 11
    v_and_b32 v22, 15, v1
    v_lshl_add_u32 v175, v22, 7, s53
    v_lshl_add_u32 v175, v26, 4, v175
    v_and_b32 v24, 16, v1
    v_lshl_add_u32 v175, v24, 1, v175
    s_lshl_b32 s52, s21, 10
    s_add_u32 s52, s52, 65536
    v_lshl_add_u32 v170, v1, 3, s52
    v_and_b32 v171, 7, v23
    v_lshl_add_u32 v171, v171, 7, s52
    v_lshl_add_u32 v171, v28, 1, v171
    ds_write2st64_b64 v170, v[116:117], v[116:117] offset1:1
    s_movk_i32 s40, 0x78
    v_lshlrev_b32 v177, 3, v22
    v_and_or_b32 v180, v173, s40, v171
    v_and_b32 v172, 0xffff0000, v173
    s_mov_b64 s[36:37], -1
    s_waitcnt vmcnt(4)
    v_lshlrev_b32 v174, 16, v174
    s_barrier
    v_and_or_b32 v156, v156, s42, v54
    buffer_load_dwordx4 v156, s[48:51], 0 offen nt lds
    s_add_u32 m0, m0, 0x400
    v_and_or_b32 v157, v157, s42, v55
    buffer_load_dwordx4 v157, s[48:51], 0 offen nt lds
    s_add_u32 m0, m0, 0x400
    v_and_or_b32 v158, v158, s42, v54
    buffer_load_dwordx4 v158, s[48:51], 0 offen nt lds
    s_add_u32 m0, m0, 0x400
    v_and_or_b32 v159, v159, s42, v55
    buffer_load_dwordx4 v159, s[48:51], 0 offen nt lds
    s_add_u32 m0, m0, 0xb400
    s_and_b32 m0, m0, 0xffff
    s_cmp_eq_u32 s23, 0
    s_cbranch_scc1 L_store
    s_waitcnt vmcnt(6)
    s_cmp_eq_u32 s3, 0
    s_cbranch_scc0 L_more
L_lloop:
    s_barrier
    s_waitcnt vmcnt(4)
    s_barrier
L_join:
    s_add_u32 m0, s41, 32768
    s_nop 0
    buffer_load_dwordx4 v2, s[48:51], 0 offen nt lds
    s_add_u32 m0, s41, 33792
    s_nop 0
    buffer_load_dwordx4 v3, s[48:51], 0 offen nt lds
    ds_read_b64_tr_b16 v[132:133], v60 offset:16384
    ds_read_b64_tr_b16 v[134:135], v60 offset:18432
    ds_read_b64_tr_b16 v[136:137], v61 offset:16384
    ds_read_b64_tr_b16 v[138:139], v61 offset:18432
    ds_read_b64_tr_b16 v[140:141], v62 offset:16384
    ds_read_b64_tr_b16 v[142:143], v62 offset:18432
    ds_read_b64_tr_b16 v[144:145], v63 offset:16384
    ds_read_b64_tr_b16 v[146:147], v63 offset:18432
    s_waitcnt vmcnt(4)
    s_barrier
    ds_read_b32 v168, v57 offset:5760
    ds_read_b32 v169, v57 offset:10880
    ds_read_b32 v173, v57 offset:512
    s_add_u32 m0, s41, 34816
    s_nop 0
    buffer_load_dwordx4 v4, s[48:51], 0 offen nt lds
    s_add_u32 m0, s41, 35840
    s_nop 0
    buffer_load_dwordx4 v5, s[48:51], 0 offen nt lds
    s_setprio 3
    s_waitcnt lgkmcnt(1)
    v_add_f32 v168, v168, v169
    v_fma_f32 v168, v168, s46, v174
    v_mul_legacy_f32 v168, v168, v172
    v_cvt_pk_bf16_f32 v168, v168, v168
    ds_write_b16 v180, v168
    ds_read2st64_b64 v[164:167], v170 offset1:1
    ds_write_b16 v180, v172
    ds_read_u16_d16_hi v172, v57 offset:514
    s_waitcnt lgkmcnt(4)
    v_and_or_b32 v180, v173, s40, v171
    s_setprio 0
    s_waitcnt vmcnt(4) lgkmcnt(0)
    s_setprio 3
    s_barrier
    v_mfma_f32_16x16x32_bf16 v[116:119], v[132:135], v[164:167], v[116:119]
    v_mfma_f32_16x16x32_bf16 v[120:123], v[136:139], v[164:167], v[120:123]
    v_mfma_f32_16x16x32_bf16 v[124:127], v[140:143], v[164:167], v[124:127]
    v_mfma_f32_16x16x32_bf16 v[128:131], v[144:147], v[164:167], v[128:131]
    s_setprio 0
    ds_read_b64_tr_b16 v[132:133], v60 offset:0
    ds_read_b64_tr_b16 v[134:135], v60 offset:2048
    ds_read_b64_tr_b16 v[136:137], v61 offset:0
    ds_read_b64_tr_b16 v[138:139], v61 offset:2048
    ds_read_b64_tr_b16 v[140:141], v62 offset:0
    ds_read_b64_tr_b16 v[142:143], v62 offset:2048
    ds_read_b64_tr_b16 v[144:145], v63 offset:0
    ds_read_b64_tr_b16 v[146:147], v63 offset:2048
    s_add_u32 m0, s41, 16384
    s_nop 0
    buffer_load_dwordx4 v6, s[48:51], 0 offen nt lds
    s_waitcnt vmcnt(3)
    s_barrier
    ds_read_b32 v168, v57 offset:5632
    ds_read_b32 v169, v57 offset:10752
    ds_read_b32 v173, v57 offset:384
    s_add_u32 m0, s41, 17408
    s_nop 0
    buffer_load_dwordx4 v7, s[48:51], 0 offen nt lds
    s_setprio 3
    s_waitcnt lgkmcnt(1)
    v_add_f32 v168, v168, v169
    v_fma_f32 v168, v168, s46, v174
    v_mul_legacy_f32 v168, v168, v172
    v_cvt_pk_bf16_f32 v168, v168, v168
    ds_write_b16 v180, v168
    ds_read2st64_b64 v[164:167], v170 offset1:1
    ds_write_b16 v180, v172
    ds_read_u16_d16_hi v172, v57 offset:386
    s_waitcnt lgkmcnt(4)
    v_and_or_b32 v180, v173, s40, v171
    s_setprio 0
    s_add_u32 m0, s41, 18432
    s_nop 0
    buffer_load_dwordx4 v8, s[48:51], 0 offen nt lds
    s_waitcnt vmcnt(3) lgkmcnt(0)
    s_setprio 3
    s_barrier
    v_mfma_f32_16x16x32_bf16 v[116:119], v[132:135], v[164:167], v[116:119]
    v_mfma_f32_16x16x32_bf16 v[120:123], v[136:139], v[164:167], v[120:123]
    v_mfma_f32_16x16x32_bf16 v[124:127], v[140:143], v[164:167], v[124:127]
    v_mfma_f32_16x16x32_bf16 v[128:131], v[144:147], v[164:167], v[128:131]
    s_setprio 0
    s_add_u32 m0, s41, 19456
    s_nop 0
    buffer_load_dwordx4 v9, s[48:51], 0 offen nt lds
    ds_read_b64_tr_b16 v[132:133], v60 offset:49152
    ds_read_b64_tr_b16 v[134:135], v60 offset:51200
    ds_read_b64_tr_b16 v[136:137], v61 offset:49152
    ds_read_b64_tr_b16 v[138:139], v61 offset:51200
    ds_read_b64_tr_b16 v[140:141], v62 offset:49152
    ds_read_b64_tr_b16 v[142:143], v62 offset:51200
    ds_read_b64_tr_b16 v[144:145], v63 offset:49152
    ds_read_b64_tr_b16 v[146:147], v63 offset:51200
    s_add_u32 m0, s41, 0
    s_nop 0
    buffer_load_dwordx4 v10, s[48:51], 0 offen nt lds
    s_waitcnt vmcnt(3)
    s_barrier
    ds_read_b32 v168, v57 offset:5504
    ds_read_b32 v169, v57 offset:10624
    ds_read_b32 v173, v57 offset:256
    s_add_u32 m0, s41, 1024
    s_nop 0
    buffer_load_dwordx4 v11, s[48:51], 0 offen nt lds
    s_setprio 3
    s_waitcnt lgkmcnt(1)
    v_add_f32 v168, v168, v169
    v_fma_f32 v168, v168, s46, v174
    v_mul_legacy_f32 v168, v168, v172
    v_cvt_pk_bf16_f32 v168, v168, v168
    ds_write_b16 v180, v168
    ds_read2st64_b64 v[164:167], v170 offset1:1
    ds_write_b16 v180, v172
    ds_read_u16_d16_hi v172, v57 offset:258
    s_waitcnt lgkmcnt(4)
    v_and_or_b32 v180, v173, s40, v171
    s_setprio 0
    s_add_u32 m0, s41, 2048
    s_nop 0
    buffer_load_dwordx4 v12, s[48:51], 0 offen nt lds
    s_waitcnt vmcnt(3) lgkmcnt(0)
    s_setprio 3
    s_barrier
    v_mfma_f32_16x16x32_bf16 v[116:119], v[132:135], v[164:167], v[116:119]
    v_mfma_f32_16x16x32_bf16 v[120:123], v[136:139], v[164:167], v[120:123]
    v_mfma_f32_16x16x32_bf16 v[124:127], v[140:143], v[164:167], v[124:127]
    v_mfma_f32_16x16x32_bf16 v[128:131], v[144:147], v[164:167], v[128:131]
    s_setprio 0
    s_add_u32 m0, s41, 3072
    s_nop 0
    buffer_load_dwordx4 v13, s[48:51], 0 offen nt lds
    ds_read_b64_tr_b16 v[132:133], v60 offset:32768
    ds_read_b64_tr_b16 v[134:135], v60 offset:34816
    ds_read_b64_tr_b16 v[136:137], v61 offset:32768
    ds_read_b64_tr_b16 v[138:139], v61 offset:34816
    ds_read_b64_tr_b16 v[140:141], v62 offset:32768
    ds_read_b64_tr_b16 v[142:143], v62 offset:34816
    ds_read_b64_tr_b16 v[144:145], v63 offset:32768
    ds_read_b64_tr_b16 v[146:147], v63 offset:34816
    s_waitcnt vmcnt(2)
    s_barrier
    ds_read_b32 v168, v57 offset:5376
    ds_read_b32 v169, v57 offset:10496
    ds_read_b32 v173, v57 offset:128
    s_setprio 3
    s_waitcnt lgkmcnt(1)
    v_add_f32 v168, v168, v169
    v_fma_f32 v168, v168, s46, v174
    v_mul_legacy_f32 v168, v168, v172
    v_cvt_pk_bf16_f32 v168, v168, v168
    ds_write_b16 v180, v168
    ds_read2st64_b64 v[164:167], v170 offset1:1
    ds_write_b16 v180, v172
    ds_read_u16_d16_hi v172, v57 offset:130
    s_waitcnt lgkmcnt(4)
    v_and_or_b32 v180, v173, s40, v171
    s_setprio 0
    s_waitcnt vmcnt(0) lgkmcnt(0)
    s_setprio 3
    s_barrier
    v_mfma_f32_16x16x32_bf16 v[116:119], v[132:135], v[164:167], v[116:119]
    v_mfma_f32_16x16x32_bf16 v[120:123], v[136:139], v[164:167], v[120:123]
    v_mfma_f32_16x16x32_bf16 v[124:127], v[140:143], v[164:167], v[124:127]
    v_mfma_f32_16x16x32_bf16 v[128:131], v[144:147], v[164:167], v[128:131]
    s_setprio 0
    ds_read_b64_tr_b16 v[132:133], v60 offset:16384
    ds_read_b64_tr_b16 v[134:135], v60 offset:18432
    ds_read_b64_tr_b16 v[136:137], v61 offset:16384
    ds_read_b64_tr_b16 v[138:139], v61 offset:18432
    ds_read_b64_tr_b16 v[140:141], v62 offset:16384
    ds_read_b64_tr_b16 v[142:143], v62 offset:18432
    ds_read_b64_tr_b16 v[144:145], v63 offset:16384
    ds_read_b64_tr_b16 v[146:147], v63 offset:18432
    s_barrier
    ds_read_b32 v168, v57 offset:5248
    ds_read_b32 v169, v57 offset:10368
    ds_read_b32 v173, v57 offset:0
    s_setprio 3
    s_waitcnt lgkmcnt(1)
    v_add_f32 v168, v168, v169
    v_fma_f32 v168, v168, s46, v174
    v_mul_legacy_f32 v168, v168, v172
    v_cvt_pk_bf16_f32 v168, v168, v168
    ds_write_b16 v180, v168
    ds_read2st64_b64 v[164:167], v170 offset1:1
    ds_write_b16 v180, v172
    ds_read_u16_d16_hi v172, v57 offset:2
    s_waitcnt lgkmcnt(4)
    v_and_or_b32 v180, v173, s40, v171
    s_setprio 0
    s_waitcnt lgkmcnt(0)
    s_setprio 3
    s_barrier
    v_mfma_f32_16x16x32_bf16 v[116:119], v[132:135], v[164:167], v[116:119]
    v_mfma_f32_16x16x32_bf16 v[120:123], v[136:139], v[164:167], v[120:123]
    v_mfma_f32_16x16x32_bf16 v[124:127], v[140:143], v[164:167], v[124:127]
    v_mfma_f32_16x16x32_bf16 v[128:131], v[144:147], v[164:167], v[128:131]
    s_setprio 0
    ds_read_b64_tr_b16 v[132:133], v60 offset:0
    ds_read_b64_tr_b16 v[134:135], v60 offset:2048
    ds_read_b64_tr_b16 v[136:137], v61 offset:0
    ds_read_b64_tr_b16 v[138:139], v61 offset:2048
    ds_read_b64_tr_b16 v[140:141], v62 offset:0
    ds_read_b64_tr_b16 v[142:143], v62 offset:2048
    ds_read_b64_tr_b16 v[144:145], v63 offset:0
    ds_read_b64_tr_b16 v[146:147], v63 offset:2048
    s_cmp_gt_u32 s23, 1
    s_cbranch_scc0 L_ne
    s_setprio 3
    v_readlane_b32 s52, v173, 31
    v_cvt_pk_bf16_f32 v184, v116, v117
    v_cvt_pk_bf16_f32 v185, v118, v119
    v_cvt_pk_bf16_f32 v186, v120, v121
    v_cvt_pk_bf16_f32 v187, v122, v123
    v_cvt_pk_bf16_f32 v188, v124, v125
    v_cvt_pk_bf16_f32 v189, v126, v127
    v_cvt_pk_bf16_f32 v190, v128, v129
    v_cvt_pk_bf16_f32 v191, v130, v131
    s_and_b32 s52, s52, 0x78
    v_cmp_ge_u32_e64 s[36:37], s52, v177
    v_permlane16_swap_b32 v184, v186
    v_permlane16_swap_b32 v185, v187
    v_permlane16_swap_b32 v188, v190
    v_permlane16_swap_b32 v189, v191
    s_setprio 0
    s_not_b64 exec, s[36:37]
    global_store_dwordx4 v175, v[184:187], s[18:19] offset:0 sc1
    global_store_dwordx4 v175, v[188:191], s[18:19] offset:64 sc1
    s_mov_b64 exec, -1
L_ne:
    s_barrier
    ds_read_b32 v168, v57 offset:5120
    ds_read_b32 v169, v57 offset:10240
    s_waitcnt lgkmcnt(0)
    v_add_f32 v168, v168, v169
    v_fma_f32 v168, v168, s46, v174
    v_mul_legacy_f32 v168, v168, v172
    v_cvt_pk_bf16_f32 v168, v168, v168
    ds_write_b16 v180, v168
    ds_read2st64_b64 v[164:167], v170 offset1:1
    s_waitcnt lgkmcnt(0)
    v_mfma_f32_16x16x32_bf16 v[116:119], v[132:135], v[164:167], v[116:119]
    v_mfma_f32_16x16x32_bf16 v[120:123], v[136:139], v[164:167], v[120:123]
    v_mfma_f32_16x16x32_bf16 v[124:127], v[140:143], v[164:167], v[124:127]
    v_mfma_f32_16x16x32_bf16 v[128:131], v[144:147], v[164:167], v[128:131]
    s_nop 0
L_store:
    s_nop 3
    v_cvt_pk_bf16_f32 v184, v116, v117
    v_cvt_pk_bf16_f32 v186, v120, v121
    v_cvt_pk_bf16_f32 v185, v118, v119
    v_cvt_pk_bf16_f32 v187, v122, v123
    s_mov_b64 exec, s[36:37]
    v_permlane16_swap_b32 v184, v186
    v_permlane16_swap_b32 v185, v187
    global_store_dwordx4 v175, v[184:187], s[18:19] offset:0 sc1
    v_cvt_pk_bf16_f32 v188, v124, v125
    v_cvt_pk_bf16_f32 v190, v128, v129
    v_cvt_pk_bf16_f32 v189, v126, v127
    v_cvt_pk_bf16_f32 v191, v130, v131
    s_nop 0
    v_permlane16_swap_b32 v188, v190
    v_permlane16_swap_b32 v189, v191
    global_store_dwordx4 v175, v[188:191], s[18:19] offset:64 sc1
    s_endpgm
L_c1:
    v_add_u32 v2, s52, v24
    v_and_b32 v22, 3, v1
    v_lshlrev_b32 v23, 4, v22
    v_mov_b32 v160, 1
    v_mov_b32 v161, 0
    v_lshlrev_b64 v[160:161], v23, v[160:161]
    v_mul_u32_u24 v12, 0x3f80, v160
    v_mul_u32_u24 v13, 0x3f80, v161
    v_mul_u32_u24 v14, 0xbf80, v160
    v_mul_u32_u24 v15, 0xbf80, v161
    v_mov_b64 v[144:145], 0
    v_mov_b64 v[146:147], 0
    v_mov_b64 v[148:149], 0
    v_mov_b64 v[150:151], 0
    s_mov_b32 s53, 111616
    v_lshl_add_u32 v23, v1, 3, s53
    v_lshl_add_u32 v165, v25, 7, s53
    s_mov_b32 exec_lo, 0x00f0000f
    s_mov_b32 exec_hi, 0xf0000f00
    v_mov_b64 v[148:149], v[12:13]
    v_mul_u32_u24 v144, 0x3f5f, v160
    v_mul_u32_u24 v145, 0x3f5f, v161
    s_mov_b64 exec, -1
    ds_write_b64 v23, v[144:145]
    v_mul_u32_u24 v160, 0xbfd4, v160
    v_mul_u32_u24 v161, 0xbfd4, v161
    s_mov_b32 s44, 0xbfb8aa3b
    s_mov_b32 s45, 0xbfb8aa3b
    s_mov_b32 s24, 0xbfd3fdf8
    s_mov_b32 s25, 0xbfd3fdf8
    s_mov_b32 s46, 0x30800000
    s_mov_b32 s47, 0x30800000
    s_movk_i32 s40, 0x78
    v_bfe_u32 v23, v1, 2, 2
    v_lshl_add_u32 v23, v25, 4, v23
    v_and_b32 v24, 24, v1
    v_lshl_add_u32 v24, v22, 1, v24
    v_lshlrev_b32 v24, 2, v24
    v_lshl_add_u32 v188, v23, 7, v24
    v_add_u32 v188, 69632, v188
    v_xor_b32 v189, 32, v188
    v_xor_b32 v190, 64, v188
    v_xor_b32 v191, 96, v188
    s_mov_b32 s53, 110848
    v_lshl_add_u32 v4, v27, 1, s53
    v_lshl_add_u32 v3, v25, 4, s53
    v_mov_b32 v168, 0xc1f00000
    v_mov_b32 v169, 0xc1f00000
    v_mov_b32 v170, 0xc1f00000
    v_mov_b32 v171, 0xc1f00000
    s_lshl2_add_u32 s53, s21, s53
    v_mov_b32 v30, s53
    v_mov_b64 v[8:9], 0
    v_mov_b64 v[10:11], 0
    s_mul_i32 s52, s21, 1280
    s_add_u32 s52, s52, 94976
    v_bfe_u32 v23, v1, 3, 1
    v_and_b32 v24, 7, v1
    v_lshl_add_u32 v24, v24, 2, v23
    v_lshl_add_u32 v158, v24, 2, s52
    v_lshrrev_b32 v24, 5, v1
    v_mul_u32_u24 v159, 5120, v24
    v_lshrrev_b32 v24, 1, v26
    v_add_u32 v159, v24, v159
    s_movk_i32 s54, 0xff80
    s_movk_i32 s55, 0xff7f
    v_and_or_b32 v23, v1, 6, v23
    v_lshlrev_b32 v24, 1, v25
    v_xor_b32 v23, v23, v24
    s_lshl_b32 s52, s21, 12
    v_lshl_add_u32 v24, v27, 7, s52
    v_lshl_add_u32 v156, v23, 4, v24
    v_xor_b32 v157, 16, v156
    s_setprio 2
    s_waitcnt vmcnt(8)
    v_mfma_f32_4x4x4_16b_bf16 v[80:83], v[14:15], v[32:33], 0
    v_mfma_f32_4x4x4_16b_bf16 v[84:87], v[14:15], v[34:35], 0
    v_mfma_f32_4x4x4_16b_bf16 v[88:91], v[14:15], v[44:45], 0
    v_mfma_f32_4x4x4_16b_bf16 v[92:95], v[14:15], v[46:47], 0
    v_mfma_f32_4x4x4_16b_bf16 v[64:67], v[12:13], v[32:33], 0
    v_mfma_f32_4x4x4_16b_bf16 v[68:71], v[12:13], v[34:35], 0
    v_mfma_f32_4x4x4_16b_bf16 v[72:75], v[12:13], v[44:45], 0
    v_mfma_f32_4x4x4_16b_bf16 v[76:79], v[12:13], v[46:47], 0
    s_waitcnt vmcnt(6)
    v_mfma_f32_4x4x4_16b_bf16 v[80:83], v[12:13], v[40:41], v[80:83]
    v_mfma_f32_4x4x4_16b_bf16 v[84:87], v[12:13], v[42:43], v[84:87]
    v_mfma_f32_4x4x4_16b_bf16 v[88:91], v[12:13], v[52:53], v[88:91]
    v_mfma_f32_4x4x4_16b_bf16 v[92:95], v[12:13], v[54:55], v[92:95]
    s_waitcnt vmcnt(4)
    v_mfma_f32_4x4x4_16b_bf16 v[64:67], v[12:13], v[36:37], v[64:67]
    v_mfma_f32_4x4x4_16b_bf16 v[68:71], v[12:13], v[38:39], v[68:71]
    v_mfma_f32_4x4x4_16b_bf16 v[72:75], v[12:13], v[48:49], v[72:75]
    v_mfma_f32_4x4x4_16b_bf16 v[76:79], v[12:13], v[50:51], v[76:79]
    v_pk_mul_f32 v[80:81], v[80:81], s[24:25]
    v_pk_mul_f32 v[82:83], v[82:83], s[24:25]
    v_pk_mul_f32 v[84:85], v[84:85], s[24:25]
    v_pk_mul_f32 v[86:87], v[86:87], s[24:25]
    v_cvt_pk_bf16_f32 v80, v80, v81
    v_cvt_pk_bf16_f32 v81, v82, v83
    v_cvt_pk_bf16_f32 v82, v84, v85
    v_cvt_pk_bf16_f32 v83, v86, v87
    ds_write_b128 v2, v[80:83] offset:16384
    v_pk_mul_f32 v[88:89], v[88:89], s[24:25]
    v_pk_mul_f32 v[90:91], v[90:91], s[24:25]
    v_pk_mul_f32 v[92:93], v[92:93], s[24:25]
    v_pk_mul_f32 v[94:95], v[94:95], s[24:25]
    v_cvt_pk_bf16_f32 v88, v88, v89
    v_cvt_pk_bf16_f32 v89, v90, v91
    v_cvt_pk_bf16_f32 v90, v92, v93
    v_cvt_pk_bf16_f32 v91, v94, v95
    ds_write_b128 v2, v[88:91] offset:17408
    v_pk_mul_f32 v[64:65], v[64:65], s[44:45]
    v_pk_mul_f32 v[66:67], v[66:67], s[44:45]
    v_pk_mul_f32 v[68:69], v[68:69], s[44:45]
    v_pk_mul_f32 v[70:71], v[70:71], s[44:45]
    v_cvt_pk_bf16_f32 v64, v64, v65
    v_cvt_pk_bf16_f32 v65, v66, v67
    v_cvt_pk_bf16_f32 v66, v68, v69
    v_cvt_pk_bf16_f32 v67, v70, v71
    ds_write_b128 v2, v[64:67] offset:0
    v_pk_mul_f32 v[72:73], v[72:73], s[44:45]
    v_pk_mul_f32 v[74:75], v[74:75], s[44:45]
    v_pk_mul_f32 v[76:77], v[76:77], s[44:45]
    v_pk_mul_f32 v[78:79], v[78:79], s[44:45]
    v_cvt_pk_bf16_f32 v72, v72, v73
    v_cvt_pk_bf16_f32 v73, v74, v75
    v_cvt_pk_bf16_f32 v74, v76, v77
    v_cvt_pk_bf16_f32 v75, v78, v79
    ds_write_b128 v2, v[72:75] offset:1024
    s_waitcnt lgkmcnt(0)
    s_barrier
    ds_read_b32 v24, v30 offset:256
    ds_read_b64_tr_b16 v[64:65], v188 offset:16384
    ds_read_b64_tr_b16 v[66:67], v188 offset:16896
    ds_read_b64_tr_b16 v[68:69], v188 offset:17408
    ds_read_b64_tr_b16 v[70:71], v188 offset:17920
    ds_read_b64_tr_b16 v[72:73], v189 offset:16384
    ds_read_b64_tr_b16 v[74:75], v189 offset:16896
    ds_read_b64_tr_b16 v[76:77], v189 offset:17408
    ds_read_b64_tr_b16 v[78:79], v189 offset:17920
    ds_read_u16_d16_hi v8, v4 offset:0
    ds_read_u16_d16_hi v9, v4 offset:32
    ds_read_u16_d16_hi v10, v4 offset:64
    ds_read_u16_d16_hi v11, v4 offset:96
    s_waitcnt lgkmcnt(12)
    v_lshl_add_u32 v158, v24, 7, v158
    v_readfirstlane_b32 s23, v24
    ds_read2_b32 v[166:167], v158 offset0:32 offset1:34
    ds_read_b32 v162, v158
    ds_read_b128 v[112:115], v3 offset:384
    ds_read_b128 v[116:119], v3 offset:448
    ds_read_b128 v[120:123], v3 offset:512
    ds_read_b128 v[124:127], v3 offset:576
    ds_read_b64_tr_b16 v[80:81], v190 offset:16384
    ds_read_b64_tr_b16 v[82:83], v190 offset:16896
    ds_read_b64_tr_b16 v[84:85], v190 offset:17408
    ds_read_b64_tr_b16 v[86:87], v190 offset:17920
    ds_read_b64_tr_b16 v[88:89], v191 offset:16384
    ds_read_b64_tr_b16 v[90:91], v191 offset:16896
    ds_read_b64_tr_b16 v[92:93], v191 offset:17408
    ds_read_b64_tr_b16 v[94:95], v191 offset:17920
    v_add_u32 v159, v159, v158
    s_max_u32 s3, s23, 6
    s_sub_u32 s3, s3, s23
    s_lshl_b32 s3, s3, 1
    s_add_u32 s52, s23, 3
    s_lshl_b32 s52, s52, 14
    s_waitcnt lgkmcnt(8)
    v_and_or_b32 v166, v166, s40, v165
    v_and_or_b32 v167, v167, s40, v165
    ds_read_b64 v[152:153], v166
    ds_read_b64 v[154:155], v167
    ds_read_b64_tr_b16 a[0:1], v188 offset:0
    ds_read_b64_tr_b16 a[2:3], v188 offset:512
    ds_read_b64_tr_b16 a[4:5], v188 offset:1024
    ds_read_b64_tr_b16 a[6:7], v188 offset:1536
    ds_read_b64_tr_b16 a[16:17], v189 offset:0
    v_pk_mul_f32 v[96:97], v[8:9], s[24:25] op_sel:[0,0] op_sel_hi:[0,1]
    v_pk_mul_f32 v[98:99], v[8:9], s[24:25] op_sel:[0,0] op_sel_hi:[0,1]
    v_pk_mul_f32 v[100:101], v[8:9], s[24:25] op_sel:[1,0] op_sel_hi:[1,1]
    v_pk_mul_f32 v[102:103], v[8:9], s[24:25] op_sel:[1,0] op_sel_hi:[1,1]
    v_pk_mul_f32 v[104:105], v[10:11], s[24:25] op_sel:[0,0] op_sel_hi:[0,1]
    v_pk_mul_f32 v[106:107], v[10:11], s[24:25] op_sel:[0,0] op_sel_hi:[0,1]
    v_pk_mul_f32 v[108:109], v[10:11], s[24:25] op_sel:[1,0] op_sel_hi:[1,1]
    v_pk_mul_f32 v[110:111], v[10:11], s[24:25] op_sel:[1,0] op_sel_hi:[1,1]
    v_pk_mul_f32 v[172:173], v[112:113], s[46:47]
    v_pk_mul_f32 v[174:175], v[114:115], s[46:47]
    v_pk_mul_f32 v[176:177], v[116:117], s[46:47]
    v_pk_mul_f32 v[178:179], v[118:119], s[46:47]
    v_pk_mul_f32 v[180:181], v[120:121], s[46:47]
    v_pk_mul_f32 v[182:183], v[122:123], s[46:47]
    v_pk_mul_f32 v[184:185], v[124:125], s[46:47]
    v_pk_mul_f32 v[186:187], v[126:127], s[46:47]
    ds_read_b64_tr_b16 a[18:19], v189 offset:512
    ds_read_b64_tr_b16 a[20:21], v189 offset:1024
    ds_read_b64_tr_b16 a[22:23], v189 offset:1536
    ds_read_b64_tr_b16 a[32:33], v190 offset:0
    ds_read_b64_tr_b16 a[34:35], v190 offset:512
    ds_read_b64_tr_b16 a[36:37], v190 offset:1024
    ds_read_b64_tr_b16 a[38:39], v190 offset:1536
    ds_read_b64_tr_b16 a[48:49], v191 offset:0
    ds_read_b64_tr_b16 a[50:51], v191 offset:512
    ds_read_b64_tr_b16 a[52:53], v191 offset:1024
    ds_read_b64_tr_b16 a[54:55], v191 offset:1536
    v_and_or_b32 v166, v162, s40, v165
    v_add_u16 v156, s52, v156
    v_add_u16 v157, s52, v157
    s_waitcnt vmcnt(2) lgkmcnt(15)
    v_mfma_f32_16x16x32_bf16 v[16:19], v[56:59], v[148:151], 0
    v_mfma_f32_16x16x32_bf16 v[20:23], v[56:59], v[146:149], 0
    v_mfma_f32_16x16x32_bf16 v[24:27], v[60:63], v[148:151], 0
    v_mfma_f32_16x16x32_bf16 v[28:31], v[60:63], v[146:149], 0
    v_mfma_f32_16x16x32_bf16 v[96:99], v[56:59], v[64:67], v[96:99]
    v_mfma_f32_16x16x32_bf16 v[96:99], v[60:63], v[68:71], v[96:99]
    v_mfma_f32_16x16x32_bf16 v[100:103], v[56:59], v[72:75], v[100:103]
    v_mfma_f32_16x16x32_bf16 v[100:103], v[60:63], v[76:79], v[100:103]
    v_mfma_f32_16x16x32_bf16 v[104:107], v[56:59], v[80:83], v[104:107]
    v_cvt_pk_bf16_f32 v128, v16, v17
    v_cvt_pk_bf16_f32 v129, v18, v19
    v_mfma_f32_16x16x32_bf16 v[104:107], v[60:63], v[84:87], v[104:107]
    v_cvt_pk_bf16_f32 v130, v20, v21
    v_cvt_pk_bf16_f32 v131, v22, v23
    v_mfma_f32_16x16x32_bf16 v[108:111], v[56:59], v[88:91], v[108:111]
    v_cvt_pk_bf16_f32 v132, v24, v25
    v_cvt_pk_bf16_f32 v133, v26, v27
    v_mfma_f32_16x16x32_bf16 v[108:111], v[60:63], v[92:95], v[108:111]
    v_cvt_pk_bf16_f32 v134, v28, v29
    v_cvt_pk_bf16_f32 v135, v30, v31
    v_mfma_f32_16x16x16_bf16 v[32:35], v[128:129], v[152:153], 0
    v_cvt_pk_bf16_f32 v136, v96, v97
    v_cvt_pk_bf16_f32 v137, v98, v99
    v_mfma_f32_16x16x16_bf16 v[36:39], v[130:131], v[152:153], 0
    v_cvt_pk_bf16_f32 v138, v100, v101
    v_cvt_pk_bf16_f32 v139, v102, v103
    v_mfma_f32_16x16x16_bf16 v[40:43], v[132:133], v[152:153], 0
    v_cvt_pk_bf16_f32 v140, v104, v105
    v_cvt_pk_bf16_f32 v141, v106, v107
    v_mfma_f32_16x16x16_bf16 v[44:47], v[134:135], v[152:153], 0
    v_cvt_pk_bf16_f32 v142, v108, v109
    v_cvt_pk_bf16_f32 v143, v110, v111
    v_mfma_f32_16x16x16_bf16 v[0:3], v[136:137], v[152:153], v[168:171]
    v_mfma_f32_16x16x16_bf16 v[4:7], v[138:139], v[152:153], v[168:171]
    v_mfma_f32_16x16x16_bf16 v[8:11], v[140:141], v[152:153], v[168:171]
    v_mfma_f32_16x16x16_bf16 v[12:15], v[142:143], v[152:153], v[168:171]
    s_sub_u32 s23, s23, 1
    s_waitcnt vmcnt(0)
    s_cbranch_scc1 L_cexit
    s_cmp_lg_u32 s3, 0
    s_barrier
    ds_read_b128 v[96:99], v156 offset:0
    ds_read_b128 v[100:103], v157 offset:0
    ds_read_b128 v[104:107], v156 offset:2048
    ds_read_b128 v[108:111], v157 offset:2048
    ds_read_b64_tr_b16 a[8:9], v188 offset:8192
    ds_read_b64_tr_b16 a[10:11], v188 offset:8704
    ds_read_b64_tr_b16 a[12:13], v188 offset:9216
    ds_read_b64_tr_b16 a[14:15], v188 offset:9728
    ds_read_b64_tr_b16 a[24:25], v189 offset:8192
    ds_read_b64_tr_b16 a[26:27], v189 offset:8704
    ds_read_b64_tr_b16 a[28:29], v189 offset:9216
    ds_read_b64_tr_b16 a[30:31], v189 offset:9728
    ds_read_b64 v[152:153], v166
    v_mfma_f32_16x16x16_bf16 v[48:51], v[128:129], v[154:155], 0
    v_mfma_f32_16x16x16_bf16 v[52:55], v[130:131], v[154:155], 0
    v_mfma_f32_16x16x16_bf16 v[56:59], v[132:133], v[154:155], 0
    v_mfma_f32_16x16x16_bf16 v[60:63], v[134:135], v[154:155], 0
    s_cbranch_scc1 L_skip
    s_waitcnt lgkmcnt(11)
L_fill:
    v_mfma_f32_4x4x4_16b_bf16 v[64:67], v[160:161], v[96:97], 0
    v_mfma_f32_4x4x4_16b_bf16 v[68:71], v[160:161], v[98:99], 0
    v_mfma_f32_4x4x4_16b_bf16 v[72:75], v[160:161], v[100:101], 0
    v_mfma_f32_4x4x4_16b_bf16 v[76:79], v[160:161], v[102:103], 0
    v_mfma_f32_16x16x32_bf16 v[0:3], a[0:3], v[96:99], v[0:3]
    ds_read_b64_tr_b16 a[40:41], v190 offset:8192
    v_mul_f32 v64, v64, v32
    v_mul_f32 v65, v65, v33
    v_mfma_f32_16x16x32_bf16 v[0:3], a[4:7], v[100:103], v[0:3]
    ds_read_b64_tr_b16 a[42:43], v190 offset:8704
    v_mul_f32 v66, v66, v34
    v_mul_f32 v67, v67, v35
    v_mul_f32 v68, v68, v36
    v_mfma_f32_16x16x32_bf16 v[4:7], a[16:19], v[96:99], v[4:7]
    ds_read_b64_tr_b16 a[44:45], v190 offset:9216
    v_mul_f32 v69, v69, v37
    v_mul_f32 v70, v70, v38
    v_mul_f32 v71, v71, v39
    v_mfma_f32_16x16x32_bf16 v[4:7], a[20:23], v[100:103], v[4:7]
    ds_read_b64_tr_b16 a[46:47], v190 offset:9728
    v_cvt_pk_bf16_f32 v64, v64, v65
    v_cvt_pk_bf16_f32 v65, v66, v67
    v_cvt_pk_bf16_f32 v66, v68, v69
    v_mfma_f32_16x16x32_bf16 v[8:11], a[32:35], v[96:99], v[8:11]
    ds_read_b64_tr_b16 a[56:57], v191 offset:8192
    v_cvt_pk_bf16_f32 v67, v70, v71
    v_mul_f32 v72, v72, v40
    v_mul_f32 v73, v73, v41
    v_mfma_f32_16x16x32_bf16 v[8:11], a[36:39], v[100:103], v[8:11]
    ds_read_b64_tr_b16 a[58:59], v191 offset:8704
    v_mul_f32 v74, v74, v42
    v_mul_f32 v75, v75, v43
    v_mul_f32 v76, v76, v44
    v_mfma_f32_16x16x32_bf16 v[12:15], a[48:51], v[96:99], v[12:15]
    ds_read_b64_tr_b16 a[60:61], v191 offset:9216
    v_mul_f32 v77, v77, v45
    v_mul_f32 v78, v78, v46
    v_mul_f32 v79, v79, v47
    v_mfma_f32_16x16x32_bf16 v[12:15], a[52:55], v[100:103], v[12:15]
    ds_read_b64_tr_b16 a[62:63], v191 offset:9728
    v_cvt_pk_bf16_f32 v68, v72, v73
    s_waitcnt lgkmcnt(8)
    s_cbranch_scc1 L_skip2
L_fill2:
    v_mfma_f32_4x4x4_16b_bf16 v[80:83], v[160:161], v[104:105], 0
    v_cvt_pk_bf16_f32 v69, v74, v75
    v_mfma_f32_4x4x4_16b_bf16 v[84:87], v[160:161], v[106:107], 0
    v_cvt_pk_bf16_f32 v70, v76, v77
    v_mfma_f32_4x4x4_16b_bf16 v[88:91], v[160:161], v[108:109], 0
    v_cvt_pk_bf16_f32 v71, v78, v79
    v_mfma_f32_4x4x4_16b_bf16 v[92:95], v[160:161], v[110:111], 0
    s_waitcnt lgkmcnt(0)
    v_mfma_f32_16x16x32_bf16 v[0:3], a[8:11], v[64:67], v[0:3]
    v_mul_f32 v80, v80, v48
    v_mul_f32 v81, v81, v49
    v_mfma_f32_16x16x32_bf16 v[0:3], a[12:15], v[68:71], v[0:3]
    v_mul_f32 v82, v82, v50
    v_mul_f32 v83, v83, v51
    v_mfma_f32_16x16x32_bf16 v[4:7], a[24:27], v[64:67], v[4:7]
    v_mul_f32 v84, v84, v52
    v_mul_f32 v85, v85, v53
    v_mfma_f32_16x16x32_bf16 v[4:7], a[28:31], v[68:71], v[4:7]
    v_mul_f32 v86, v86, v54
    v_mul_f32 v87, v87, v55
    v_mfma_f32_16x16x32_bf16 v[8:11], a[40:43], v[64:67], v[8:11]
    v_mul_f32 v88, v88, v56
    v_mul_f32 v89, v89, v57
    v_mfma_f32_16x16x32_bf16 v[8:11], a[44:47], v[68:71], v[8:11]
    v_mul_f32 v90, v90, v58
    v_mul_f32 v91, v91, v59
    v_mfma_f32_16x16x32_bf16 v[12:15], a[56:59], v[64:67], v[12:15]
    v_mul_f32 v92, v92, v60
    v_mul_f32 v93, v93, v61
    v_mfma_f32_16x16x32_bf16 v[12:15], a[60:63], v[68:71], v[12:15]
    v_mul_f32 v94, v94, v62
    v_mul_f32 v95, v95, v63
    v_mfma_f32_16x16x16_bf16 v[16:19], v[136:137], v[154:155], v[168:171]
    v_add_u16 v156, 0xc000, v156
    v_add_u16 v157, 0xc000, v157
    .p2align 3
L_alpha:
    v_mfma_f32_16x16x16_bf16 v[20:23], v[138:139], v[154:155], v[168:171]
    v_rcp_f32 v146, v146
    v_cvt_pk_bf16_f32 v80, v80, v81
    v_mfma_f32_16x16x16_bf16 v[24:27], v[140:141], v[154:155], v[168:171]
    v_rcp_f32 v147, v147
    v_cvt_pk_bf16_f32 v81, v82, v83
    v_mfma_f32_16x16x16_bf16 v[28:31], v[142:143], v[154:155], v[168:171]
    v_rcp_f32 v150, v150
    v_mul_f32 v164, v144, v146
    v_mfma_f32_16x16x32_bf16 v[16:19], a[0:3], v[104:107], v[16:19]
    s_sub_u32 s23, s23, 1
    v_rcp_f32 v151, v151
    v_mfma_f32_16x16x32_bf16 v[16:19], a[4:7], v[108:111], v[16:19]
    v_fmac_f32 v164, v145, v147
    v_fmac_f32 v164, v148, v150
    v_mfma_f32_16x16x32_bf16 v[20:23], a[16:19], v[104:107], v[20:23]
    v_fmac_f32 v164, v149, v151
    v_cvt_pk_bf16_f32 v82, v84, v85
    v_mfma_f32_16x16x32_bf16 v[20:23], a[20:23], v[108:111], v[20:23]
    v_cvt_pk_bf16_f32 v83, v86, v87
    v_permlane16_swap_b32 v162, v164
    v_mfma_f32_16x16x32_bf16 v[24:27], a[32:35], v[104:107], v[24:27]
    v_cvt_pk_bf16_f32 v84, v88, v89
    v_add_f32_e64 v162, v162, v164
    v_mfma_f32_16x16x32_bf16 v[24:27], a[36:39], v[108:111], v[24:27]
    ds_write_b32 v159, v162 offset:5376
    v_mfma_f32_16x16x32_bf16 v[28:31], a[48:51], v[104:107], v[28:31]
    v_cvt_pk_bf16_f32 v85, v90, v91
    v_cvt_pk_bf16_f32 v86, v92, v93
    v_mfma_f32_16x16x32_bf16 v[28:31], a[52:55], v[108:111], v[28:31]
    v_cvt_pk_bf16_f32 v87, v94, v95
    v_exp_f32_e64 v0, v0 clamp
    v_mfma_f32_16x16x32_bf16 v[16:19], a[8:11], v[80:83], v[16:19]
    v_exp_f32_e64 v1, v1 clamp
    v_mfma_f32_16x16x32_bf16 v[16:19], a[12:15], v[84:87], v[16:19]
    s_waitcnt lgkmcnt(0)
    s_barrier
    v_mfma_f32_16x16x32_bf16 v[20:23], a[24:27], v[80:83], v[20:23]
    ds_read_b128 v[96:99], v156 offset:0
    ds_read_b128 v[100:103], v157 offset:0
    v_mfma_f32_16x16x32_bf16 v[20:23], a[28:31], v[84:87], v[20:23]
    v_exp_f32_e64 v2, v2 clamp
    v_mfma_f32_16x16x32_bf16 v[24:27], a[40:43], v[80:83], v[24:27]
    v_exp_f32_e64 v3, v3 clamp
    v_mfma_f32_16x16x32_bf16 v[24:27], a[44:47], v[84:87], v[24:27]
    v_exp_f32_e64 v4, v4 clamp
    v_mfma_f32_16x16x32_bf16 v[28:31], a[56:59], v[80:83], v[28:31]
    v_exp_f32_e64 v5, v5 clamp
    v_mfma_f32_16x16x32_bf16 v[28:31], a[60:63], v[84:87], v[28:31]
    s_cbranch_scc1 L_drain
    v_exp_f32_e64 v6, v6 clamp
    v_mfma_f32_16x16x16_bf16 v[32:35], v[128:129], v[152:153], 0
    v_exp_f32_e64 v7, v7 clamp
    v_exp_f32_e64 v8, v8 clamp
    v_mfma_f32_16x16x16_bf16 v[36:39], v[130:131], v[152:153], 0
    v_exp_f32_e64 v9, v9 clamp
    v_mfma_f32_16x16x16_bf16 v[40:43], v[132:133], v[152:153], 0
    v_exp_f32_e64 v10, v10 clamp
    v_exp_f32_e64 v11, v11 clamp
    v_mfma_f32_16x16x16_bf16 v[44:47], v[134:135], v[152:153], 0
    s_waitcnt lgkmcnt(0)
    v_exp_f32_e64 v12, v12 clamp
    v_mfma_f32_4x4x4_16b_bf16 v[64:67], v[160:161], v[96:97], 0
    v_lshl_add_u64 v[158:159], v[158:159], 0, s[54:55]
    v_mfma_f32_4x4x4_16b_bf16 v[68:71], v[160:161], v[98:99], 0
    v_exp_f32_e64 v13, v13 clamp
    v_mfma_f32_4x4x4_16b_bf16 v[72:75], v[160:161], v[100:101], 0
    v_mfma_f32_4x4x4_16b_bf16 v[76:79], v[160:161], v[102:103], 0
    v_exp_f32_e64 v14, v14 clamp
    v_exp_f32_e64 v15, v15 clamp
    v_pk_fma_f32 v[0:1], v[0:1], v[112:113], v[172:173]
    v_pk_fma_f32 v[2:3], v[2:3], v[114:115], v[174:175]
    v_pk_fma_f32 v[4:5], v[4:5], v[116:117], v[176:177]
    v_pk_fma_f32 v[6:7], v[6:7], v[118:119], v[178:179]
    v_pk_fma_f32 v[8:9], v[8:9], v[120:121], v[180:181]
    v_pk_fma_f32 v[10:11], v[10:11], v[122:123], v[182:183]
    v_pk_fma_f32 v[12:13], v[12:13], v[124:125], v[184:185]
    v_pk_fma_f32 v[14:15], v[14:15], v[126:127], v[186:187]
    v_pk_add_f32 v[144:145], v[0:1], v[2:3]
    v_pk_mul_f32 v[0:1], v[0:1], v[2:3]
    v_pk_add_f32 v[146:147], v[4:5], v[6:7]
    v_pk_mul_f32 v[4:5], v[4:5], v[6:7]
    v_pk_add_f32 v[148:149], v[8:9], v[10:11]
    v_pk_mul_f32 v[8:9], v[8:9], v[10:11]
    v_pk_add_f32 v[150:151], v[12:13], v[14:15]
    v_pk_mul_f32 v[12:13], v[12:13], v[14:15]
    v_pk_mul_f32 v[144:145], v[144:145], v[4:5]
    v_pk_fma_f32 v[144:145], v[146:147], v[0:1], v[144:145]
    v_pk_mul_f32 v[146:147], v[0:1], v[4:5]
    v_pk_mul_f32 v[148:149], v[148:149], v[12:13]
    v_pk_fma_f32 v[148:149], v[150:151], v[8:9], v[148:149]
    v_pk_mul_f32 v[150:151], v[8:9], v[12:13]
    v_pk_mul_f32 v[64:65], v[64:65], v[32:33]
    v_pk_mul_f32 v[66:67], v[66:67], v[34:35]
    v_pk_mul_f32 v[68:69], v[68:69], v[36:37]
    v_pk_mul_f32 v[70:71], v[70:71], v[38:39]
    v_pk_mul_f32 v[72:73], v[72:73], v[40:41]
    v_pk_mul_f32 v[74:75], v[74:75], v[42:43]
    v_pk_mul_f32 v[76:77], v[76:77], v[44:45]
    v_pk_mul_f32 v[78:79], v[78:79], v[46:47]
    v_mfma_f32_16x16x16_bf16 v[0:3], v[136:137], v[152:153], v[168:171]
    v_cvt_pk_bf16_f32 v64, v64, v65
    v_cvt_pk_bf16_f32 v65, v66, v67
    v_cvt_pk_bf16_f32 v66, v68, v69
    v_mfma_f32_16x16x16_bf16 v[4:7], v[138:139], v[152:153], v[168:171]
    v_rcp_f32 v146, v146
    v_cvt_pk_bf16_f32 v67, v70, v71
    v_mfma_f32_16x16x16_bf16 v[8:11], v[140:141], v[152:153], v[168:171]
    v_rcp_f32 v147, v147
    v_cvt_pk_bf16_f32 v68, v72, v73
    v_mfma_f32_16x16x16_bf16 v[12:15], v[142:143], v[152:153], v[168:171]
    v_rcp_f32 v150, v150
    v_cvt_pk_bf16_f32 v69, v74, v75
    v_mfma_f32_16x16x32_bf16 v[0:3], a[0:3], v[96:99], v[0:3]
    ds_read2_b32 v[166:167], v158 offset1:34
    v_cvt_pk_bf16_f32 v70, v76, v77
    v_mfma_f32_16x16x32_bf16 v[0:3], a[4:7], v[100:103], v[0:3]
    v_rcp_f32 v151, v151
    v_mfma_f32_16x16x32_bf16 v[4:7], a[16:19], v[96:99], v[4:7]
    v_cvt_pk_bf16_f32 v71, v78, v79
    v_mul_f32 v162, v144, v146
    v_mfma_f32_16x16x32_bf16 v[4:7], a[20:23], v[100:103], v[4:7]
    v_fmac_f32 v162, v145, v147
    v_fmac_f32 v162, v148, v150
    v_mfma_f32_16x16x32_bf16 v[8:11], a[32:35], v[96:99], v[8:11]
    v_exp_f32_e64 v16, v16 clamp
    v_mfma_f32_16x16x32_bf16 v[8:11], a[36:39], v[100:103], v[8:11]
    s_waitcnt lgkmcnt(0)
    v_and_or_b32 v166, v166, s40, v165
    v_and_or_b32 v167, v167, s40, v165
    v_mfma_f32_16x16x32_bf16 v[12:15], a[48:51], v[96:99], v[12:15]
    ds_read_b64 v[154:155], v167
    ds_read_b64 v[152:153], v166
    v_mfma_f32_16x16x32_bf16 v[12:15], a[52:55], v[100:103], v[12:15]
    v_exp_f32_e64 v17, v17 clamp
    v_mfma_f32_16x16x32_bf16 v[0:3], a[8:11], v[64:67], v[0:3]
    v_exp_f32_e64 v18, v18 clamp
    v_mfma_f32_16x16x32_bf16 v[0:3], a[12:15], v[68:71], v[0:3]
    s_barrier
    ds_read_b128 v[104:107], v156 offset:2048
    v_mfma_f32_16x16x32_bf16 v[4:7], a[24:27], v[64:67], v[4:7]
    ds_read_b128 v[108:111], v157 offset:2048
    v_exp_f32_e64 v19, v19 clamp
    v_mfma_f32_16x16x32_bf16 v[4:7], a[28:31], v[68:71], v[4:7]
    v_exp_f32_e64 v20, v20 clamp
    v_mfma_f32_16x16x32_bf16 v[8:11], a[40:43], v[64:67], v[8:11]
    v_exp_f32_e64 v21, v21 clamp
    v_mfma_f32_16x16x32_bf16 v[8:11], a[44:47], v[68:71], v[8:11]
    v_exp_f32_e64 v22, v22 clamp
    v_mfma_f32_16x16x32_bf16 v[12:15], a[56:59], v[64:67], v[12:15]
    v_exp_f32_e64 v23, v23 clamp
    v_mfma_f32_16x16x32_bf16 v[12:15], a[60:63], v[68:71], v[12:15]
    s_waitcnt lgkmcnt(2)
    v_exp_f32_e64 v24, v24 clamp
    v_mfma_f32_16x16x16_bf16 v[48:51], v[128:129], v[154:155], 0
    v_exp_f32_e64 v25, v25 clamp
    v_fmac_f32 v162, v149, v151
    v_mfma_f32_16x16x16_bf16 v[52:55], v[130:131], v[154:155], 0
    v_exp_f32_e64 v26, v26 clamp
    v_add_u16 v156, 0xc000, v156
    v_mfma_f32_16x16x16_bf16 v[56:59], v[132:133], v[154:155], 0
    v_exp_f32_e64 v27, v27 clamp
    v_add_u16 v157, 0xc000, v157
    v_mfma_f32_16x16x16_bf16 v[60:63], v[134:135], v[154:155], 0
    s_waitcnt lgkmcnt(0)
    v_exp_f32_e64 v28, v28 clamp
    v_mfma_f32_4x4x4_16b_bf16 v[80:83], v[160:161], v[104:105], 0
    v_mfma_f32_4x4x4_16b_bf16 v[84:87], v[160:161], v[106:107], 0
    v_exp_f32_e64 v29, v29 clamp
    v_mfma_f32_4x4x4_16b_bf16 v[88:91], v[160:161], v[108:109], 0
    v_mfma_f32_4x4x4_16b_bf16 v[92:95], v[160:161], v[110:111], 0
    v_exp_f32_e64 v30, v30 clamp
    v_exp_f32_e64 v31, v31 clamp
    v_pk_fma_f32 v[16:17], v[16:17], v[112:113], v[172:173]
    v_pk_fma_f32 v[18:19], v[18:19], v[114:115], v[174:175]
    v_pk_fma_f32 v[20:21], v[20:21], v[116:117], v[176:177]
    v_pk_fma_f32 v[22:23], v[22:23], v[118:119], v[178:179]
    v_pk_fma_f32 v[24:25], v[24:25], v[120:121], v[180:181]
    v_pk_fma_f32 v[26:27], v[26:27], v[122:123], v[182:183]
    v_pk_fma_f32 v[28:29], v[28:29], v[124:125], v[184:185]
    v_pk_fma_f32 v[30:31], v[30:31], v[126:127], v[186:187]
    v_pk_add_f32 v[144:145], v[16:17], v[18:19]
    v_pk_mul_f32 v[16:17], v[16:17], v[18:19]
    v_pk_add_f32 v[146:147], v[20:21], v[22:23]
    v_pk_mul_f32 v[20:21], v[20:21], v[22:23]
    v_pk_add_f32 v[148:149], v[24:25], v[26:27]
    v_pk_mul_f32 v[24:25], v[24:25], v[26:27]
    v_pk_add_f32 v[150:151], v[28:29], v[30:31]
    v_pk_mul_f32 v[28:29], v[28:29], v[30:31]
    v_pk_mul_f32 v[144:145], v[144:145], v[20:21]
    v_pk_fma_f32 v[144:145], v[146:147], v[16:17], v[144:145]
    v_pk_mul_f32 v[146:147], v[16:17], v[20:21]
    v_pk_mul_f32 v[148:149], v[148:149], v[28:29]
    v_pk_fma_f32 v[148:149], v[150:151], v[24:25], v[148:149]
    v_pk_mul_f32 v[150:151], v[24:25], v[28:29]
    v_pk_mul_f32 v[80:81], v[80:81], v[48:49]
    v_pk_mul_f32 v[82:83], v[82:83], v[50:51]
    v_pk_mul_f32 v[84:85], v[84:85], v[52:53]
    v_pk_mul_f32 v[86:87], v[86:87], v[54:55]
    v_pk_mul_f32 v[88:89], v[88:89], v[56:57]
    v_pk_mul_f32 v[90:91], v[90:91], v[58:59]
    v_pk_mul_f32 v[92:93], v[92:93], v[60:61]
    v_pk_mul_f32 v[94:95], v[94:95], v[62:63]
    v_mfma_f32_16x16x16_bf16 v[16:19], v[136:137], v[154:155], v[168:171]
    s_branch L_alpha
    .p2align 3
L_drain:
    v_exp_f32_e64 v6, v6 clamp
    v_exp_f32_e64 v7, v7 clamp
    v_exp_f32_e64 v8, v8 clamp
    v_exp_f32_e64 v9, v9 clamp
    v_exp_f32_e64 v10, v10 clamp
    v_exp_f32_e64 v11, v11 clamp
    v_exp_f32_e64 v12, v12 clamp
    v_exp_f32_e64 v13, v13 clamp
    v_exp_f32_e64 v14, v14 clamp
    v_exp_f32_e64 v15, v15 clamp
    v_pk_fma_f32 v[0:1], v[0:1], v[112:113], v[172:173]
    v_pk_fma_f32 v[2:3], v[2:3], v[114:115], v[174:175]
    v_pk_fma_f32 v[4:5], v[4:5], v[116:117], v[176:177]
    v_pk_fma_f32 v[6:7], v[6:7], v[118:119], v[178:179]
    v_pk_fma_f32 v[8:9], v[8:9], v[120:121], v[180:181]
    v_pk_fma_f32 v[10:11], v[10:11], v[122:123], v[182:183]
    v_pk_fma_f32 v[12:13], v[12:13], v[124:125], v[184:185]
    v_pk_fma_f32 v[14:15], v[14:15], v[126:127], v[186:187]
    v_pk_add_f32 v[144:145], v[0:1], v[2:3]
    v_pk_mul_f32 v[0:1], v[0:1], v[2:3]
    v_pk_add_f32 v[146:147], v[4:5], v[6:7]
    v_pk_mul_f32 v[4:5], v[4:5], v[6:7]
    v_pk_add_f32 v[148:149], v[8:9], v[10:11]
    v_pk_mul_f32 v[8:9], v[8:9], v[10:11]
    v_pk_add_f32 v[150:151], v[12:13], v[14:15]
    v_pk_mul_f32 v[12:13], v[12:13], v[14:15]
    v_pk_mul_f32 v[144:145], v[144:145], v[4:5]
    v_pk_fma_f32 v[144:145], v[146:147], v[0:1], v[144:145]
    v_pk_mul_f32 v[146:147], v[0:1], v[4:5]
    v_pk_mul_f32 v[148:149], v[148:149], v[12:13]
    v_pk_fma_f32 v[148:149], v[150:151], v[8:9], v[148:149]
    v_pk_mul_f32 v[150:151], v[8:9], v[12:13]
    s_barrier
    v_rcp_f32 v146, v146
    v_rcp_f32 v147, v147
    v_rcp_f32 v150, v150
    v_rcp_f32_e64 v151, v151
    v_exp_f32_e64 v16, v16 clamp
    v_exp_f32_e64 v17, v17 clamp
    v_exp_f32_e64 v18, v18 clamp
    v_exp_f32_e64 v19, v19 clamp
    v_exp_f32_e64 v20, v20 clamp
    v_exp_f32_e64 v21, v21 clamp
    v_exp_f32_e64 v22, v22 clamp
    v_exp_f32_e64 v23, v23 clamp
    v_exp_f32_e64 v24, v24 clamp
    v_exp_f32_e64 v25, v25 clamp
    v_exp_f32_e64 v26, v26 clamp
    v_exp_f32_e64 v27, v27 clamp
    v_exp_f32_e64 v28, v28 clamp
    v_exp_f32_e64 v29, v29 clamp
    v_exp_f32_e64 v30, v30 clamp
    v_exp_f32_e64 v31, v31 clamp
    v_pk_mul_f32 v[162:163], v[144:145], v[146:147]
    v_pk_fma_f32 v[162:163], v[148:149], v[150:151], v[162:163]
    v_add_f32_e64 v162, v162, v163
    v_pk_fma_f32 v[16:17], v[16:17], v[112:113], v[172:173]
    v_pk_fma_f32 v[18:19], v[18:19], v[114:115], v[174:175]
    v_pk_fma_f32 v[20:21], v[20:21], v[116:117], v[176:177]
    v_pk_fma_f32 v[22:23], v[22:23], v[118:119], v[178:179]
    v_pk_fma_f32 v[24:25], v[24:25], v[120:121], v[180:181]
    v_pk_fma_f32 v[26:27], v[26:27], v[122:123], v[182:183]
    v_pk_fma_f32 v[28:29], v[28:29], v[124:125], v[184:185]
    v_pk_fma_f32 v[30:31], v[30:31], v[126:127], v[186:187]
    v_pk_add_f32 v[144:145], v[16:17], v[18:19]
    v_pk_mul_f32 v[16:17], v[16:17], v[18:19]
    v_pk_add_f32 v[146:147], v[20:21], v[22:23]
    v_pk_mul_f32 v[20:21], v[20:21], v[22:23]
    v_pk_add_f32 v[148:149], v[24:25], v[26:27]
    v_pk_mul_f32 v[24:25], v[24:25], v[26:27]
    v_pk_add_f32 v[150:151], v[28:29], v[30:31]
    v_pk_mul_f32 v[28:29], v[28:29], v[30:31]
    v_pk_mul_f32 v[144:145], v[144:145], v[20:21]
    v_pk_fma_f32 v[144:145], v[146:147], v[16:17], v[144:145]
    v_pk_mul_f32 v[146:147], v[16:17], v[20:21]
    v_pk_mul_f32 v[148:149], v[148:149], v[28:29]
    v_pk_fma_f32 v[148:149], v[150:151], v[24:25], v[148:149]
    v_pk_mul_f32 v[150:151], v[24:25], v[28:29]
    v_rcp_f32 v146, v146
    v_rcp_f32 v147, v147
    v_rcp_f32 v150, v150
    v_rcp_f32 v151, v151
    v_pk_mul_f32 v[164:165], v[144:145], v[146:147]
    v_pk_fma_f32 v[164:165], v[148:149], v[150:151], v[164:165]
    v_add_f32_e64 v164, v164, v165
    s_nop 1
    v_permlane16_swap_b32 v162, v164
    v_add_f32 v162, v162, v164
    ds_write_b32 v159, v162 offset:5248
    s_waitcnt lgkmcnt(0)
    s_barrier
L_cexit:
    s_endpgm
L_skip:
    s_barrier
    s_sub_u32 s3, s3, 1
    s_cmp_eq_u32 s3, 1
    s_cbranch_scc0 L_skip
    ds_read_b128 v[96:99], v156 offset:0
    ds_read_b128 v[100:103], v157 offset:0
    s_waitcnt lgkmcnt(0)
    s_branch L_fill
L_skip2:
    s_barrier
    ds_read_b128 v[104:107], v156 offset:2048
    ds_read_b128 v[108:111], v157 offset:2048
    s_waitcnt lgkmcnt(0)
    s_branch L_fill2
L_more:
    s_setprio 3
    v_mov_b64 v[132:133], 0
    v_mov_b64 v[134:135], 0
    v_mov_b64 v[136:137], 0
    v_mov_b64 v[138:139], 0
    v_mov_b64 v[140:141], 0
    v_mov_b64 v[142:143], 0
    v_mov_b64 v[144:145], 0
    v_mov_b64 v[146:147], 0
    v_mov_b32 v172, 0
L_more2:
    s_barrier
    ds_read_b32 v168, v59 offset:5888
    ds_read_b32 v169, v59 offset:11008
    ds_read_b32 v173, v59 offset:640
    s_setprio 3
    s_waitcnt lgkmcnt(1)
    v_add_f32 v168, v168, v169
    v_fma_f32 v168, v168, s46, v174
    v_mul_legacy_f32 v168, v168, v172
    v_cvt_pk_bf16_f32 v168, v168, v168
    ds_write_b16 v180, v168
    ds_read2st64_b64 v[164:167], v170 offset1:1
    ds_write_b16 v180, v172
    ds_read_u16_d16_hi v172, v59 offset:642
    s_waitcnt lgkmcnt(4)
    v_and_or_b32 v180, v173, s40, v171
    ds_read_b128 v[148:151], v58 offset:256
    v_add_u32 v72, s43, v60
    v_add_u32 v73, s43, v61
    v_add_u32 v74, s43, v62
    v_add_u32 v75, s43, v63
    s_add_u32 s52, s43, 0x4000
    s_and_b32 s52, s52, 0xffff
    s_add_u32 m0, s52, s41
    s_add_u32 s43, s43, 0xc000
    s_and_b32 s43, s43, 0xffff
    v_subrev_u32 v58, 0x80, v58
    v_subrev_u32 v59, 0x80, v59
    s_setprio 0
    s_waitcnt vmcnt(4) lgkmcnt(0)
    s_setprio 3
    s_barrier
    v_mfma_f32_16x16x32_bf16 v[116:119], v[132:135], v[164:167], v[116:119]
    v_mfma_f32_16x16x32_bf16 v[120:123], v[136:139], v[164:167], v[120:123]
    v_mfma_f32_16x16x32_bf16 v[124:127], v[140:143], v[164:167], v[124:127]
    v_mfma_f32_16x16x32_bf16 v[128:131], v[144:147], v[164:167], v[128:131]
    ds_read_b64_tr_b16 v[132:133], v72 offset:0
    ds_read_b64_tr_b16 v[134:135], v72 offset:2048
    ds_read_b64_tr_b16 v[136:137], v73 offset:0
    ds_read_b64_tr_b16 v[138:139], v73 offset:2048
    ds_read_b64_tr_b16 v[140:141], v74 offset:0
    ds_read_b64_tr_b16 v[142:143], v74 offset:2048
    ds_read_b64_tr_b16 v[144:145], v75 offset:0
    ds_read_b64_tr_b16 v[146:147], v75 offset:2048
    v_and_or_b32 v148, v148, s42, v54
    buffer_load_dwordx4 v148, s[48:51], 0 offen nt lds
    s_add_u32 m0, m0, 0x400
    v_and_or_b32 v149, v149, s42, v55
    buffer_load_dwordx4 v149, s[48:51], 0 offen nt lds
    s_add_u32 m0, m0, 0x400
    v_and_or_b32 v150, v150, s42, v54
    buffer_load_dwordx4 v150, s[48:51], 0 offen nt lds
    s_add_u32 m0, m0, 0x400
    v_and_or_b32 v151, v151, s42, v55
    buffer_load_dwordx4 v151, s[48:51], 0 offen nt lds
    s_add_u32 m0, m0, 0xb400
    s_and_b32 m0, m0, 0xffff
    s_setprio 0
    s_sub_u32 s3, s3, 1
    s_cmp_eq_u32 s3, 0
    s_waitcnt vmcnt(6)
    s_cbranch_scc0 L_more2
    s_barrier
    ds_read_b32 v168, v57 offset:5888
    ds_read_b32 v169, v57 offset:11008
    ds_read_b32 v173, v57 offset:640
    s_setprio 3
    s_waitcnt lgkmcnt(1)
    v_add_f32 v168, v168, v169
    v_fma_f32 v168, v168, s46, v174
    v_mul_legacy_f32 v168, v168, v172
    v_cvt_pk_bf16_f32 v168, v168, v168
    ds_write_b16 v180, v168
    ds_read2st64_b64 v[164:167], v170 offset1:1
    ds_write_b16 v180, v172
    ds_read_u16_d16_hi v172, v57 offset:642
    s_waitcnt lgkmcnt(4)
    v_and_or_b32 v180, v173, s40, v171
    s_setprio 0
    s_waitcnt vmcnt(4) lgkmcnt(0)
    s_setprio 3
    s_barrier
    v_mfma_f32_16x16x32_bf16 v[116:119], v[132:135], v[164:167], v[116:119]
    v_mfma_f32_16x16x32_bf16 v[120:123], v[136:139], v[164:167], v[120:123]
    v_mfma_f32_16x16x32_bf16 v[124:127], v[140:143], v[164:167], v[124:127]
    v_mfma_f32_16x16x32_bf16 v[128:131], v[144:147], v[164:167], v[128:131]
    s_setprio 0
    s_branch L_join
L_fin:
L_end:
    s_endpgm
.section .rodata,"a"
.p2align 6
.amdhsa_kernel standalone__sequential_behavior_din__recsys_kernel
  .amdhsa_next_free_vgpr 256
  .amdhsa_next_free_sgpr 100
  .amdhsa_accum_offset 192
  .amdhsa_group_segment_fixed_size 0
  .amdhsa_kernarg_size 80
  .amdhsa_user_sgpr_count 2
  .amdhsa_user_sgpr_kernarg_segment_ptr 1
  .amdhsa_system_sgpr_workgroup_id_x 1
.end_amdhsa_kernel
```
